```python
import torch

def _softmax(x, axis=-1):
    return torch.softmax(x, dim=axis)
def _gelu(x):
    return torch.nn.functional.gelu(x, approximate="tanh")
def _silu(x):
    return torch.nn.functional.silu(x)
def _sigmoid(x):
    return torch.sigmoid(x)
def _layernorm(x, axis=-1, eps=1e-5):
    m = x.mean(dim=axis, keepdim=True)
    v = x.var(dim=axis, keepdim=True, unbiased=False)
    return (x - m) / torch.sqrt(v + eps)
def _scatter_add(tgt, idx, src, axis=0):
    return tgt.clone().index_add_(axis, idx, src)
def _segment_sum(src, seg, n):
    out = torch.zeros((n,) + src.shape[1:], dtype=src.dtype)
    return out.index_add_(0, seg, src)
def _pad(x, pw):
    flat = tuple(v for pair in reversed(pw) for v in pair)
    return torch.nn.functional.pad(x, flat)

kernel_name = 'standalone__deepnorm__sampling'

def setup_inputs():

    _w = (lambda a: (lambda t: t.to(torch.bfloat16) if t.is_floating_point() else t)(torch.as_tensor(a)))
    B, S, D = 1024, 8, 640
    return {
        "x": _w((lambda *s: torch.randn(*s, dtype=torch.bfloat16) * 0.05)(B, S, D)),
        "f": _w((lambda *s: torch.randn(*s, dtype=torch.bfloat16) * 0.05)(B, S, D)),
        "g": _w((lambda *s: torch.randn(*s, dtype=torch.bfloat16) * 0.05)(D) + 1.0),
        "b": _w((lambda *s: torch.randn(*s, dtype=torch.bfloat16) * 0.4)(D)),
        "alpha": _w(float(2.0)),
    }

def reference(x, f, g, b, alpha):
    return _layernorm(alpha * x + f, axis=-1) * g + b
```

```asm
; @launch grid=(256,1,1) block=(1024,1,1) lds=5120
.amdgcn_target "amdgcn-amd-amdhsa--gfx950"
.text
.globl standalone__deepnorm__sampling_kernel
.p2align 13
.p2align 8
.type standalone__deepnorm__sampling_kernel,@function
standalone__deepnorm__sampling_kernel:
    s_load_dwordx8 s[4:11], s[0:1], 0
    s_load_dwordx4 s[12:15], s[0:1], 32
    s_cmp_ge_u32 s2, 256
    s_cbranch_scc1 L_end
    v_readfirstlane_b32 s22, v0
    v_and_b32 v108, 31, v0
    v_lshlrev_b32 v3, 4, v108
    v_lshlrev_b32 v4, 3, v108
    s_mul_i32 s3, s2, 40960
    v_lshrrev_b32 v109, 5, v0
    v_mul_u32_u24 v109, 1280, v109
    v_add3_u32 v1, v109, v3, s3
    v_add3_u32 v2, v109, v4, s3
    s_mov_b32 s16, 0xffff0000
    s_cmp_ge_u32 s22, 64
    s_waitcnt lgkmcnt(0)
    s_cbranch_scc1 L_nogb
    global_load_dwordx4 v[24:27], v3, s[8:9] offset:0
    global_load_dwordx4 v[28:31], v3, s[8:9] offset:512
    global_load_dwordx2 v[44:45], v4, s[8:9] offset:1024
    global_load_dwordx4 v[32:35], v3, s[10:11] offset:0
    global_load_dwordx4 v[36:39], v3, s[10:11] offset:512
    global_load_dwordx2 v[46:47], v4, s[10:11] offset:1024
L_nogb:
    global_load_dwordx4 v[8:11], v1, s[4:5] offset:0 nt
    global_load_dwordx4 v[16:19], v1, s[6:7] offset:0 nt
    global_load_dwordx4 v[12:15], v1, s[4:5] offset:512 nt
    global_load_dwordx4 v[20:23], v1, s[6:7] offset:512 nt
    global_load_dwordx2 v[40:41], v2, s[4:5] offset:1024 nt
    global_load_dwordx2 v[42:43], v2, s[6:7] offset:1024 nt
    s_load_dword s17, s[12:13], 0
    v_mov_b32 v5, 0x3acccccd
    v_mov_b32 v6, 0x3727c5ac
    s_cbranch_scc1 L_bar
    s_waitcnt vmcnt(6)
    v_lshlrev_b32 v48, 16, v24
    v_and_b32 v49, s16, v24
    v_lshlrev_b32 v50, 16, v25
    v_and_b32 v51, s16, v25
    v_lshlrev_b32 v52, 16, v26
    v_and_b32 v53, s16, v26
    v_lshlrev_b32 v54, 16, v27
    v_and_b32 v55, s16, v27
    v_lshlrev_b32 v56, 16, v28
    v_and_b32 v57, s16, v28
    v_lshlrev_b32 v58, 16, v29
    v_and_b32 v59, s16, v29
    v_lshlrev_b32 v60, 16, v30
    v_and_b32 v61, s16, v30
    v_lshlrev_b32 v62, 16, v31
    v_and_b32 v63, s16, v31
    v_lshlrev_b32 v64, 16, v44
    v_and_b32 v65, s16, v44
    v_lshlrev_b32 v66, 16, v45
    v_and_b32 v67, s16, v45
    v_lshlrev_b32 v68, 16, v32
    v_and_b32 v69, s16, v32
    v_lshlrev_b32 v70, 16, v33
    v_and_b32 v71, s16, v33
    v_lshlrev_b32 v72, 16, v34
    v_and_b32 v73, s16, v34
    v_lshlrev_b32 v74, 16, v35
    v_and_b32 v75, s16, v35
    v_lshlrev_b32 v76, 16, v36
    v_and_b32 v77, s16, v36
    v_lshlrev_b32 v78, 16, v37
    v_and_b32 v79, s16, v37
    v_lshlrev_b32 v80, 16, v38
    v_and_b32 v81, s16, v38
    v_lshlrev_b32 v82, 16, v39
    v_and_b32 v83, s16, v39
    v_lshlrev_b32 v84, 16, v46
    v_and_b32 v85, s16, v46
    v_lshlrev_b32 v86, 16, v47
    v_and_b32 v87, s16, v47
    ds_write_b128 v3, v[48:51] offset:0
    ds_write_b128 v3, v[52:55] offset:512
    ds_write_b128 v3, v[56:59] offset:1024
    ds_write_b128 v3, v[60:63] offset:1536
    ds_write_b128 v3, v[64:67] offset:2048
    ds_write_b128 v3, v[68:71] offset:2560
    ds_write_b128 v3, v[72:75] offset:3072
    ds_write_b128 v3, v[76:79] offset:3584
    ds_write_b128 v3, v[80:83] offset:4096
    ds_write_b128 v3, v[84:87] offset:4608
    s_waitcnt lgkmcnt(0)
L_bar:
    s_barrier
    ds_read_b128 v[48:51], v3 offset:0
    ds_read_b128 v[52:55], v3 offset:512
    ds_read_b128 v[56:59], v3 offset:1024
    ds_read_b128 v[60:63], v3 offset:1536
    ds_read_b128 v[64:67], v3 offset:2048
    ds_read_b128 v[68:71], v3 offset:2560
    ds_read_b128 v[72:75], v3 offset:3072
    ds_read_b128 v[76:79], v3 offset:3584
    ds_read_b128 v[80:83], v3 offset:4096
    ds_read_b128 v[84:87], v3 offset:4608
    s_waitcnt lgkmcnt(0)
    s_and_b32 s18, s17, 0xffff
    s_lshl_b32 s19, s17, 16
    s_waitcnt vmcnt(4)
    v_lshlrev_b32 v88, 16, v16
    v_and_b32 v89, s16, v16
    v_lshlrev_b32 v90, 16, v17
    v_and_b32 v91, s16, v17
    v_lshlrev_b32 v92, 16, v18
    v_and_b32 v93, s16, v18
    v_lshlrev_b32 v94, 16, v19
    v_and_b32 v95, s16, v19
    v_dot2c_f32_bf16 v88, s18, v8
    v_dot2c_f32_bf16 v89, s19, v8
    v_dot2c_f32_bf16 v90, s18, v9
    v_dot2c_f32_bf16 v91, s19, v9
    v_dot2c_f32_bf16 v92, s18, v10
    v_dot2c_f32_bf16 v93, s19, v10
    v_dot2c_f32_bf16 v94, s18, v11
    v_dot2c_f32_bf16 v95, s19, v11
    v_pk_mul_f32 v[110:111], v[88:89], v[88:89]
    v_pk_add_f32 v[108:109], v[88:89], v[90:91]
    v_pk_fma_f32 v[110:111], v[90:91], v[90:91], v[110:111]
    v_pk_add_f32 v[108:109], v[108:109], v[92:93]
    v_pk_fma_f32 v[110:111], v[92:93], v[92:93], v[110:111]
    v_pk_add_f32 v[108:109], v[108:109], v[94:95]
    v_pk_fma_f32 v[110:111], v[94:95], v[94:95], v[110:111]
    s_waitcnt vmcnt(2)
    v_lshlrev_b32 v96, 16, v20
    v_and_b32 v97, s16, v20
    v_lshlrev_b32 v98, 16, v21
    v_and_b32 v99, s16, v21
    v_lshlrev_b32 v100, 16, v22
    v_and_b32 v101, s16, v22
    v_lshlrev_b32 v102, 16, v23
    v_and_b32 v103, s16, v23
    v_dot2c_f32_bf16 v96, s18, v12
    v_dot2c_f32_bf16 v97, s19, v12
    v_dot2c_f32_bf16 v98, s18, v13
    v_dot2c_f32_bf16 v99, s19, v13
    v_dot2c_f32_bf16 v100, s18, v14
    v_dot2c_f32_bf16 v101, s19, v14
    v_dot2c_f32_bf16 v102, s18, v15
    v_dot2c_f32_bf16 v103, s19, v15
    v_pk_add_f32 v[108:109], v[108:109], v[96:97]
    v_pk_fma_f32 v[110:111], v[96:97], v[96:97], v[110:111]
    v_pk_add_f32 v[108:109], v[108:109], v[98:99]
    v_pk_fma_f32 v[110:111], v[98:99], v[98:99], v[110:111]
    v_pk_add_f32 v[108:109], v[108:109], v[100:101]
    v_pk_fma_f32 v[110:111], v[100:101], v[100:101], v[110:111]
    v_pk_add_f32 v[108:109], v[108:109], v[102:103]
    v_pk_fma_f32 v[110:111], v[102:103], v[102:103], v[110:111]
    s_waitcnt vmcnt(0)
    v_lshlrev_b32 v104, 16, v42
    v_and_b32 v105, s16, v42
    v_lshlrev_b32 v106, 16, v43
    v_and_b32 v107, s16, v43
    v_dot2c_f32_bf16 v104, s18, v40
    v_dot2c_f32_bf16 v105, s19, v40
    v_dot2c_f32_bf16 v106, s18, v41
    v_dot2c_f32_bf16 v107, s19, v41
    s_nop 0
    v_pk_add_f32 v[108:109], v[108:109], v[104:105]
    v_pk_fma_f32 v[110:111], v[104:105], v[104:105], v[110:111]
    v_pk_add_f32 v[108:109], v[108:109], v[106:107]
    v_pk_fma_f32 v[110:111], v[106:107], v[106:107], v[110:111]
    s_barrier
    v_add_f32 v108, v108, v109
    v_add_f32 v110, v110, v111
    s_nop 1
    v_permlane16_swap_b32 v108, v110
    v_add_f32 v108, v108, v110
    s_nop 1
    v_add_f32_dpp v108, v108, v108 row_ror:8 row_mask:0xf bank_mask:0xf
    s_nop 1
    v_add_f32_dpp v108, v108, v108 row_ror:4 row_mask:0xf bank_mask:0xf
    s_nop 1
    v_add_f32_dpp v108, v108, v108 row_ror:2 row_mask:0xf bank_mask:0xf
    s_nop 1
    v_add_f32_dpp v110, v108, v108 row_ror:1 row_mask:0xf bank_mask:0xf
    v_add_f32_dpp v108, v108, v108 row_ror:1 row_mask:0xf bank_mask:0xf
    s_nop 1
    v_permlane16_swap_b32 v108, v110
    v_mul_f32 v108, v108, v5
    v_fma_f32 v110, v110, v5, v6
    v_fma_f32 v110, -v108, v108, v110
    v_max_f32 v110, v6, v110
    v_rsq_f32 v112, v110
    s_nop 0
    v_mul_f32_e64 v113, -v108, v112
    v_pk_fma_f32 v[88:89], v[88:89], v[112:113], v[112:113] op_sel:[0,0,1] op_sel_hi:[1,0,1]
    v_pk_fma_f32 v[90:91], v[90:91], v[112:113], v[112:113] op_sel:[0,0,1] op_sel_hi:[1,0,1]
    v_pk_fma_f32 v[92:93], v[92:93], v[112:113], v[112:113] op_sel:[0,0,1] op_sel_hi:[1,0,1]
    v_pk_fma_f32 v[94:95], v[94:95], v[112:113], v[112:113] op_sel:[0,0,1] op_sel_hi:[1,0,1]
    v_pk_fma_f32 v[88:89], v[88:89], v[48:49], v[68:69]
    v_pk_fma_f32 v[90:91], v[90:91], v[50:51], v[70:71]
    v_pk_fma_f32 v[92:93], v[92:93], v[52:53], v[72:73]
    v_pk_fma_f32 v[94:95], v[94:95], v[54:55], v[74:75]
    v_cvt_pk_bf16_f32 v8, v88, v89
    v_cvt_pk_bf16_f32 v9, v90, v91
    v_cvt_pk_bf16_f32 v10, v92, v93
    v_cvt_pk_bf16_f32 v11, v94, v95
    global_store_dwordx4 v1, v[8:11], s[14:15] offset:0 nt
    v_pk_fma_f32 v[96:97], v[96:97], v[112:113], v[112:113] op_sel:[0,0,1] op_sel_hi:[1,0,1]
    v_pk_fma_f32 v[98:99], v[98:99], v[112:113], v[112:113] op_sel:[0,0,1] op_sel_hi:[1,0,1]
    v_pk_fma_f32 v[100:101], v[100:101], v[112:113], v[112:113] op_sel:[0,0,1] op_sel_hi:[1,0,1]
    v_pk_fma_f32 v[102:103], v[102:103], v[112:113], v[112:113] op_sel:[0,0,1] op_sel_hi:[1,0,1]
    v_pk_fma_f32 v[96:97], v[96:97], v[56:57], v[76:77]
    v_pk_fma_f32 v[98:99], v[98:99], v[58:59], v[78:79]
    v_pk_fma_f32 v[100:101], v[100:101], v[60:61], v[80:81]
    v_pk_fma_f32 v[102:103], v[102:103], v[62:63], v[82:83]
    v_cvt_pk_bf16_f32 v12, v96, v97
    v_cvt_pk_bf16_f32 v13, v98, v99
    v_cvt_pk_bf16_f32 v14, v100, v101
    v_cvt_pk_bf16_f32 v15, v102, v103
    global_store_dwordx4 v1, v[12:15], s[14:15] offset:512 nt
    v_pk_fma_f32 v[104:105], v[104:105], v[112:113], v[112:113] op_sel:[0,0,1] op_sel_hi:[1,0,1]
    v_pk_fma_f32 v[106:107], v[106:107], v[112:113], v[112:113] op_sel:[0,0,1] op_sel_hi:[1,0,1]
    v_pk_fma_f32 v[104:105], v[104:105], v[64:65], v[84:85]
    v_pk_fma_f32 v[106:107], v[106:107], v[66:67], v[86:87]
    v_cvt_pk_bf16_f32 v40, v104, v105
    v_cvt_pk_bf16_f32 v41, v106, v107
    global_store_dwordx2 v2, v[40:41], s[14:15] offset:1024 nt
L_end:
    s_endpgm
.section .rodata,"a"
.p2align 6
.amdhsa_kernel standalone__deepnorm__sampling_kernel
  .amdhsa_next_free_vgpr 114
  .amdhsa_next_free_sgpr 48
  .amdhsa_accum_offset 116
  .amdhsa_group_segment_fixed_size 0
  .amdhsa_kernarg_size 64
  .amdhsa_user_sgpr_count 2
  .amdhsa_user_sgpr_kernarg_segment_ptr 1
  .amdhsa_system_sgpr_workgroup_id_x 1
  .amdhsa_float_denorm_mode_32 3
.end_amdhsa_kernel
```
